```python
import torch

def _softmax(x, axis=-1):
    return torch.softmax(x, dim=axis)
def _gelu(x):
    return torch.nn.functional.gelu(x, approximate="tanh")
def _silu(x):
    return torch.nn.functional.silu(x)
def _sigmoid(x):
    return torch.sigmoid(x)
def _layernorm(x, axis=-1, eps=1e-5):
    m = x.mean(dim=axis, keepdim=True)
    v = x.var(dim=axis, keepdim=True, unbiased=False)
    return (x - m) / torch.sqrt(v + eps)
def _scatter_add(tgt, idx, src, axis=0):
    return tgt.clone().index_add_(axis, idx, src)
def _segment_sum(src, seg, n):
    out = torch.zeros((n,) + src.shape[1:], dtype=src.dtype)
    return out.index_add_(0, seg, src)
def _pad(x, pw):
    flat = tuple(v for pair in reversed(pw) for v in pair)
    return torch.nn.functional.pad(x, flat)

kernel_name = 'standalone__channel_attn_eca__vision'

def setup_inputs():

    _w = (lambda a: (lambda t: t.to(torch.bfloat16) if t.is_floating_point() else t)(torch.as_tensor(a)))
    H = W = 512
    C = 96
    k = 1
    return {
        "x": _w((lambda *s: torch.randn(*s, dtype=torch.bfloat16) * 0.8)(1, H, W, C) + (lambda *s: torch.randn(*s, dtype=torch.bfloat16) * 0.8)(1, 1, 1, C) * 2.0),
        "w1d": _w((lambda *s: torch.randn(*s, dtype=torch.bfloat16) * 0.8)(k)),
    }

def reference(x, w1d):
    B, H, W, C = x.shape
    k = 1
    pad = k // 2
    g = torch.einsum("bhwc->bc", x) / (H * W)
    gp = _pad(g, ((0, 0), (pad, pad)))
    s = torch.zeros_like(g)
    for i in range(k):
        s = s + gp[:, i:i + C] * w1d[i]
    s = _sigmoid(s)
    return x * s[:, None, None, :]
```

```asm
; @launch grid=(256,1,1) block=(576,1,1) lds=4096
.amdgcn_target "amdgcn-amd-amdhsa--gfx950"
.text
.globl standalone__channel_attn_eca__vision_kernel
.p2align 8
.type standalone__channel_attn_eca__vision_kernel,@function
standalone__channel_attn_eca__vision_kernel:
  s_cmp_ge_u32 s2, 256
  s_cbranch_scc1 L_end
  s_load_dwordx2 s[16:17], s[0:1], 0
  s_load_dwordx2 s[20:21], s[0:1], 16
  v_lshrrev_b32 v1, 6, v0
  v_and_b32 v2, 63, v0
  v_readfirstlane_b32 s3, v1
  s_mov_b32 s18, 50331648
  s_mov_b32 s19, 0x20000
  s_cmp_eq_u32 s3, 8
  s_cbranch_scc1 L_service
L_data:
  v_lshrrev_b32 v3, 4, v2
  v_and_b32 v4, 15, v2
  s_mul_i32 s4, s2, 196608
  s_mul_i32 s5, s3, 3072
  v_mul_u32_u24 v1, 192, v3
  s_add_u32 s4, s4, s5
  v_lshl_add_u32 v1, v4, 4, v1
  s_mov_b32 exec_lo, 0x0fff0fff
  s_mov_b32 exec_hi, 0x0fff0fff
  v_add_u32 v1, s4, v1
  s_waitcnt lgkmcnt(0)
  s_mov_b32 s40, 0
  buffer_load_dwordx4 v[24:27], v1, s[16:19], s40 offen offset:0 nt
  buffer_load_dwordx4 v[28:31], v1, s[16:19], s40 offen offset:768 nt
  buffer_load_dwordx4 v[32:35], v1, s[16:19], s40 offen offset:1536 nt
  buffer_load_dwordx4 v[36:39], v1, s[16:19], s40 offen offset:2304 nt
  s_add_u32 s40, s40, 24576
  buffer_load_dwordx4 v[40:43], v1, s[16:19], s40 offen offset:0 nt
  buffer_load_dwordx4 v[44:47], v1, s[16:19], s40 offen offset:768 nt
  buffer_load_dwordx4 v[48:51], v1, s[16:19], s40 offen offset:1536 nt
  buffer_load_dwordx4 v[52:55], v1, s[16:19], s40 offen offset:2304 nt
  s_add_u32 s40, s40, 24576
  buffer_load_dwordx4 v[56:59], v1, s[16:19], s40 offen offset:0 nt
  buffer_load_dwordx4 v[60:63], v1, s[16:19], s40 offen offset:768 nt
  buffer_load_dwordx4 v[64:67], v1, s[16:19], s40 offen offset:1536 nt
  buffer_load_dwordx4 v[68:71], v1, s[16:19], s40 offen offset:2304 nt
  s_add_u32 s40, s40, 24576
  buffer_load_dwordx4 v[72:75], v1, s[16:19], s40 offen offset:0 nt
  buffer_load_dwordx4 v[76:79], v1, s[16:19], s40 offen offset:768 nt
  buffer_load_dwordx4 v[80:83], v1, s[16:19], s40 offen offset:1536 nt
  buffer_load_dwordx4 v[84:87], v1, s[16:19], s40 offen offset:2304 nt
  s_add_u32 s40, s40, 24576
  buffer_load_dwordx4 v[88:91], v1, s[16:19], s40 offen offset:0 nt
  buffer_load_dwordx4 v[92:95], v1, s[16:19], s40 offen offset:768 nt
  buffer_load_dwordx4 v[96:99], v1, s[16:19], s40 offen offset:1536 nt
  buffer_load_dwordx4 v[100:103], v1, s[16:19], s40 offen offset:2304 nt
  s_add_u32 s40, s40, 24576
  buffer_load_dwordx4 v[104:107], v1, s[16:19], s40 offen offset:0 nt
  buffer_load_dwordx4 v[108:111], v1, s[16:19], s40 offen offset:768 nt
  buffer_load_dwordx4 v[112:115], v1, s[16:19], s40 offen offset:1536 nt
  buffer_load_dwordx4 v[116:119], v1, s[16:19], s40 offen offset:2304 nt
  s_add_u32 s40, s40, 24576
  buffer_load_dwordx4 v[120:123], v1, s[16:19], s40 offen offset:0 nt
  buffer_load_dwordx4 v[124:127], v1, s[16:19], s40 offen offset:768 nt
  buffer_load_dwordx4 v[128:131], v1, s[16:19], s40 offen offset:1536 nt
  buffer_load_dwordx4 v[132:135], v1, s[16:19], s40 offen offset:2304 nt
  s_add_u32 s40, s40, 24576
  buffer_load_dwordx4 v[136:139], v1, s[16:19], s40 offen offset:0 nt
  buffer_load_dwordx4 v[140:143], v1, s[16:19], s40 offen offset:768 nt
  buffer_load_dwordx4 v[144:147], v1, s[16:19], s40 offen offset:1536 nt
  buffer_load_dwordx4 v[148:151], v1, s[16:19], s40 offen offset:2304 nt
  s_mov_b32 s22, 50331648
  s_mov_b32 s23, 0x20000
  s_mov_b64 s[48:49], -1
  v_mov_b32 v8, 0
  v_mov_b32 v9, 0
  v_mov_b32 v10, 0
  v_mov_b32 v11, 0
  v_mov_b32 v12, 0
  v_mov_b32 v13, 0
  v_mov_b32 v14, 0
  v_mov_b32 v15, 0
  v_and_b32 v5, 1, v3
  v_lshlrev_b32 v5, 1, v5
  v_lshrrev_b32 v6, 1, v3
  v_or_b32 v5, v5, v6
  v_lshlrev_b32 v5, 2, v5
  v_lshl_add_u32 v5, v4, 5, v5
  s_mul_i32 s5, s3, 384
  v_add_u32 v5, s5, v5
  v_lshlrev_b32 v4, 5, v4
L_acc:
  s_waitcnt vmcnt(28)
  v_lshlrev_b32 v16, 16, v24
  v_and_b32 v17, 0xffff0000, v24
  v_lshlrev_b32 v18, 16, v25
  v_and_b32 v19, 0xffff0000, v25
  v_lshlrev_b32 v20, 16, v26
  v_and_b32 v21, 0xffff0000, v26
  v_lshlrev_b32 v22, 16, v27
  v_and_b32 v23, 0xffff0000, v27
  v_pk_add_f32 v[8:9], v[8:9], v[16:17]
  v_pk_add_f32 v[10:11], v[10:11], v[18:19]
  v_pk_add_f32 v[12:13], v[12:13], v[20:21]
  v_pk_add_f32 v[14:15], v[14:15], v[22:23]
  v_lshlrev_b32 v16, 16, v28
  v_and_b32 v17, 0xffff0000, v28
  v_lshlrev_b32 v18, 16, v29
  v_and_b32 v19, 0xffff0000, v29
  v_lshlrev_b32 v20, 16, v30
  v_and_b32 v21, 0xffff0000, v30
  v_lshlrev_b32 v22, 16, v31
  v_and_b32 v23, 0xffff0000, v31
  v_pk_add_f32 v[8:9], v[8:9], v[16:17]
  v_pk_add_f32 v[10:11], v[10:11], v[18:19]
  v_pk_add_f32 v[12:13], v[12:13], v[20:21]
  v_pk_add_f32 v[14:15], v[14:15], v[22:23]
  v_lshlrev_b32 v16, 16, v32
  v_and_b32 v17, 0xffff0000, v32
  v_lshlrev_b32 v18, 16, v33
  v_and_b32 v19, 0xffff0000, v33
  v_lshlrev_b32 v20, 16, v34
  v_and_b32 v21, 0xffff0000, v34
  v_lshlrev_b32 v22, 16, v35
  v_and_b32 v23, 0xffff0000, v35
  v_pk_add_f32 v[8:9], v[8:9], v[16:17]
  v_pk_add_f32 v[10:11], v[10:11], v[18:19]
  v_pk_add_f32 v[12:13], v[12:13], v[20:21]
  v_pk_add_f32 v[14:15], v[14:15], v[22:23]
  v_lshlrev_b32 v16, 16, v36
  v_and_b32 v17, 0xffff0000, v36
  v_lshlrev_b32 v18, 16, v37
  v_and_b32 v19, 0xffff0000, v37
  v_lshlrev_b32 v20, 16, v38
  v_and_b32 v21, 0xffff0000, v38
  v_lshlrev_b32 v22, 16, v39
  v_and_b32 v23, 0xffff0000, v39
  v_pk_add_f32 v[8:9], v[8:9], v[16:17]
  v_pk_add_f32 v[10:11], v[10:11], v[18:19]
  v_pk_add_f32 v[12:13], v[12:13], v[20:21]
  v_pk_add_f32 v[14:15], v[14:15], v[22:23]
  s_waitcnt vmcnt(24)
  v_lshlrev_b32 v16, 16, v40
  v_and_b32 v17, 0xffff0000, v40
  v_lshlrev_b32 v18, 16, v41
  v_and_b32 v19, 0xffff0000, v41
  v_lshlrev_b32 v20, 16, v42
  v_and_b32 v21, 0xffff0000, v42
  v_lshlrev_b32 v22, 16, v43
  v_and_b32 v23, 0xffff0000, v43
  v_pk_add_f32 v[8:9], v[8:9], v[16:17]
  v_pk_add_f32 v[10:11], v[10:11], v[18:19]
  v_pk_add_f32 v[12:13], v[12:13], v[20:21]
  v_pk_add_f32 v[14:15], v[14:15], v[22:23]
  v_lshlrev_b32 v16, 16, v44
  v_and_b32 v17, 0xffff0000, v44
  v_lshlrev_b32 v18, 16, v45
  v_and_b32 v19, 0xffff0000, v45
  v_lshlrev_b32 v20, 16, v46
  v_and_b32 v21, 0xffff0000, v46
  v_lshlrev_b32 v22, 16, v47
  v_and_b32 v23, 0xffff0000, v47
  v_pk_add_f32 v[8:9], v[8:9], v[16:17]
  v_pk_add_f32 v[10:11], v[10:11], v[18:19]
  v_pk_add_f32 v[12:13], v[12:13], v[20:21]
  v_pk_add_f32 v[14:15], v[14:15], v[22:23]
  v_lshlrev_b32 v16, 16, v48
  v_and_b32 v17, 0xffff0000, v48
  v_lshlrev_b32 v18, 16, v49
  v_and_b32 v19, 0xffff0000, v49
  v_lshlrev_b32 v20, 16, v50
  v_and_b32 v21, 0xffff0000, v50
  v_lshlrev_b32 v22, 16, v51
  v_and_b32 v23, 0xffff0000, v51
  v_pk_add_f32 v[8:9], v[8:9], v[16:17]
  v_pk_add_f32 v[10:11], v[10:11], v[18:19]
  v_pk_add_f32 v[12:13], v[12:13], v[20:21]
  v_pk_add_f32 v[14:15], v[14:15], v[22:23]
  v_lshlrev_b32 v16, 16, v52
  v_and_b32 v17, 0xffff0000, v52
  v_lshlrev_b32 v18, 16, v53
  v_and_b32 v19, 0xffff0000, v53
  v_lshlrev_b32 v20, 16, v54
  v_and_b32 v21, 0xffff0000, v54
  v_lshlrev_b32 v22, 16, v55
  v_and_b32 v23, 0xffff0000, v55
  v_pk_add_f32 v[8:9], v[8:9], v[16:17]
  v_pk_add_f32 v[10:11], v[10:11], v[18:19]
  v_pk_add_f32 v[12:13], v[12:13], v[20:21]
  v_pk_add_f32 v[14:15], v[14:15], v[22:23]
  s_waitcnt vmcnt(20)
  v_lshlrev_b32 v16, 16, v56
  v_and_b32 v17, 0xffff0000, v56
  v_lshlrev_b32 v18, 16, v57
  v_and_b32 v19, 0xffff0000, v57
  v_lshlrev_b32 v20, 16, v58
  v_and_b32 v21, 0xffff0000, v58
  v_lshlrev_b32 v22, 16, v59
  v_and_b32 v23, 0xffff0000, v59
  v_pk_add_f32 v[8:9], v[8:9], v[16:17]
  v_pk_add_f32 v[10:11], v[10:11], v[18:19]
  v_pk_add_f32 v[12:13], v[12:13], v[20:21]
  v_pk_add_f32 v[14:15], v[14:15], v[22:23]
  v_lshlrev_b32 v16, 16, v60
  v_and_b32 v17, 0xffff0000, v60
  v_lshlrev_b32 v18, 16, v61
  v_and_b32 v19, 0xffff0000, v61
  v_lshlrev_b32 v20, 16, v62
  v_and_b32 v21, 0xffff0000, v62
  v_lshlrev_b32 v22, 16, v63
  v_and_b32 v23, 0xffff0000, v63
  v_pk_add_f32 v[8:9], v[8:9], v[16:17]
  v_pk_add_f32 v[10:11], v[10:11], v[18:19]
  v_pk_add_f32 v[12:13], v[12:13], v[20:21]
  v_pk_add_f32 v[14:15], v[14:15], v[22:23]
  v_lshlrev_b32 v16, 16, v64
  v_and_b32 v17, 0xffff0000, v64
  v_lshlrev_b32 v18, 16, v65
  v_and_b32 v19, 0xffff0000, v65
  v_lshlrev_b32 v20, 16, v66
  v_and_b32 v21, 0xffff0000, v66
  v_lshlrev_b32 v22, 16, v67
  v_and_b32 v23, 0xffff0000, v67
  v_pk_add_f32 v[8:9], v[8:9], v[16:17]
  v_pk_add_f32 v[10:11], v[10:11], v[18:19]
  v_pk_add_f32 v[12:13], v[12:13], v[20:21]
  v_pk_add_f32 v[14:15], v[14:15], v[22:23]
  v_lshlrev_b32 v16, 16, v68
  v_and_b32 v17, 0xffff0000, v68
  v_lshlrev_b32 v18, 16, v69
  v_and_b32 v19, 0xffff0000, v69
  v_lshlrev_b32 v20, 16, v70
  v_and_b32 v21, 0xffff0000, v70
  v_lshlrev_b32 v22, 16, v71
  v_and_b32 v23, 0xffff0000, v71
  v_pk_add_f32 v[8:9], v[8:9], v[16:17]
  v_pk_add_f32 v[10:11], v[10:11], v[18:19]
  v_pk_add_f32 v[12:13], v[12:13], v[20:21]
  v_pk_add_f32 v[14:15], v[14:15], v[22:23]
  s_waitcnt vmcnt(16)
  v_lshlrev_b32 v16, 16, v72
  v_and_b32 v17, 0xffff0000, v72
  v_lshlrev_b32 v18, 16, v73
  v_and_b32 v19, 0xffff0000, v73
  v_lshlrev_b32 v20, 16, v74
  v_and_b32 v21, 0xffff0000, v74
  v_lshlrev_b32 v22, 16, v75
  v_and_b32 v23, 0xffff0000, v75
  v_pk_add_f32 v[8:9], v[8:9], v[16:17]
  v_pk_add_f32 v[10:11], v[10:11], v[18:19]
  v_pk_add_f32 v[12:13], v[12:13], v[20:21]
  v_pk_add_f32 v[14:15], v[14:15], v[22:23]
  v_lshlrev_b32 v16, 16, v76
  v_and_b32 v17, 0xffff0000, v76
  v_lshlrev_b32 v18, 16, v77
  v_and_b32 v19, 0xffff0000, v77
  v_lshlrev_b32 v20, 16, v78
  v_and_b32 v21, 0xffff0000, v78
  v_lshlrev_b32 v22, 16, v79
  v_and_b32 v23, 0xffff0000, v79
  v_pk_add_f32 v[8:9], v[8:9], v[16:17]
  v_pk_add_f32 v[10:11], v[10:11], v[18:19]
  v_pk_add_f32 v[12:13], v[12:13], v[20:21]
  v_pk_add_f32 v[14:15], v[14:15], v[22:23]
  v_lshlrev_b32 v16, 16, v80
  v_and_b32 v17, 0xffff0000, v80
  v_lshlrev_b32 v18, 16, v81
  v_and_b32 v19, 0xffff0000, v81
  v_lshlrev_b32 v20, 16, v82
  v_and_b32 v21, 0xffff0000, v82
  v_lshlrev_b32 v22, 16, v83
  v_and_b32 v23, 0xffff0000, v83
  v_pk_add_f32 v[8:9], v[8:9], v[16:17]
  v_pk_add_f32 v[10:11], v[10:11], v[18:19]
  v_pk_add_f32 v[12:13], v[12:13], v[20:21]
  v_pk_add_f32 v[14:15], v[14:15], v[22:23]
  v_lshlrev_b32 v16, 16, v84
  v_and_b32 v17, 0xffff0000, v84
  v_lshlrev_b32 v18, 16, v85
  v_and_b32 v19, 0xffff0000, v85
  v_lshlrev_b32 v20, 16, v86
  v_and_b32 v21, 0xffff0000, v86
  v_lshlrev_b32 v22, 16, v87
  v_and_b32 v23, 0xffff0000, v87
  v_pk_add_f32 v[8:9], v[8:9], v[16:17]
  v_pk_add_f32 v[10:11], v[10:11], v[18:19]
  v_pk_add_f32 v[12:13], v[12:13], v[20:21]
  v_pk_add_f32 v[14:15], v[14:15], v[22:23]
  s_waitcnt vmcnt(12)
  v_lshlrev_b32 v16, 16, v88
  v_and_b32 v17, 0xffff0000, v88
  v_lshlrev_b32 v18, 16, v89
  v_and_b32 v19, 0xffff0000, v89
  v_lshlrev_b32 v20, 16, v90
  v_and_b32 v21, 0xffff0000, v90
  v_lshlrev_b32 v22, 16, v91
  v_and_b32 v23, 0xffff0000, v91
  v_pk_add_f32 v[8:9], v[8:9], v[16:17]
  v_pk_add_f32 v[10:11], v[10:11], v[18:19]
  v_pk_add_f32 v[12:13], v[12:13], v[20:21]
  v_pk_add_f32 v[14:15], v[14:15], v[22:23]
  v_lshlrev_b32 v16, 16, v92
  v_and_b32 v17, 0xffff0000, v92
  v_lshlrev_b32 v18, 16, v93
  v_and_b32 v19, 0xffff0000, v93
  v_lshlrev_b32 v20, 16, v94
  v_and_b32 v21, 0xffff0000, v94
  v_lshlrev_b32 v22, 16, v95
  v_and_b32 v23, 0xffff0000, v95
  v_pk_add_f32 v[8:9], v[8:9], v[16:17]
  v_pk_add_f32 v[10:11], v[10:11], v[18:19]
  v_pk_add_f32 v[12:13], v[12:13], v[20:21]
  v_pk_add_f32 v[14:15], v[14:15], v[22:23]
  v_lshlrev_b32 v16, 16, v96
  v_and_b32 v17, 0xffff0000, v96
  v_lshlrev_b32 v18, 16, v97
  v_and_b32 v19, 0xffff0000, v97
  v_lshlrev_b32 v20, 16, v98
  v_and_b32 v21, 0xffff0000, v98
  v_lshlrev_b32 v22, 16, v99
  v_and_b32 v23, 0xffff0000, v99
  v_pk_add_f32 v[8:9], v[8:9], v[16:17]
  v_pk_add_f32 v[10:11], v[10:11], v[18:19]
  v_pk_add_f32 v[12:13], v[12:13], v[20:21]
  v_pk_add_f32 v[14:15], v[14:15], v[22:23]
  v_lshlrev_b32 v16, 16, v100
  v_and_b32 v17, 0xffff0000, v100
  v_lshlrev_b32 v18, 16, v101
  v_and_b32 v19, 0xffff0000, v101
  v_lshlrev_b32 v20, 16, v102
  v_and_b32 v21, 0xffff0000, v102
  v_lshlrev_b32 v22, 16, v103
  v_and_b32 v23, 0xffff0000, v103
  v_pk_add_f32 v[8:9], v[8:9], v[16:17]
  v_pk_add_f32 v[10:11], v[10:11], v[18:19]
  v_pk_add_f32 v[12:13], v[12:13], v[20:21]
  v_pk_add_f32 v[14:15], v[14:15], v[22:23]
  s_waitcnt vmcnt(8)
  v_lshlrev_b32 v16, 16, v104
  v_and_b32 v17, 0xffff0000, v104
  v_lshlrev_b32 v18, 16, v105
  v_and_b32 v19, 0xffff0000, v105
  v_lshlrev_b32 v20, 16, v106
  v_and_b32 v21, 0xffff0000, v106
  v_lshlrev_b32 v22, 16, v107
  v_and_b32 v23, 0xffff0000, v107
  v_pk_add_f32 v[8:9], v[8:9], v[16:17]
  v_pk_add_f32 v[10:11], v[10:11], v[18:19]
  v_pk_add_f32 v[12:13], v[12:13], v[20:21]
  v_pk_add_f32 v[14:15], v[14:15], v[22:23]
  v_lshlrev_b32 v16, 16, v108
  v_and_b32 v17, 0xffff0000, v108
  v_lshlrev_b32 v18, 16, v109
  v_and_b32 v19, 0xffff0000, v109
  v_lshlrev_b32 v20, 16, v110
  v_and_b32 v21, 0xffff0000, v110
  v_lshlrev_b32 v22, 16, v111
  v_and_b32 v23, 0xffff0000, v111
  v_pk_add_f32 v[8:9], v[8:9], v[16:17]
  v_pk_add_f32 v[10:11], v[10:11], v[18:19]
  v_pk_add_f32 v[12:13], v[12:13], v[20:21]
  v_pk_add_f32 v[14:15], v[14:15], v[22:23]
  v_lshlrev_b32 v16, 16, v112
  v_and_b32 v17, 0xffff0000, v112
  v_lshlrev_b32 v18, 16, v113
  v_and_b32 v19, 0xffff0000, v113
  v_lshlrev_b32 v20, 16, v114
  v_and_b32 v21, 0xffff0000, v114
  v_lshlrev_b32 v22, 16, v115
  v_and_b32 v23, 0xffff0000, v115
  v_pk_add_f32 v[8:9], v[8:9], v[16:17]
  v_pk_add_f32 v[10:11], v[10:11], v[18:19]
  v_pk_add_f32 v[12:13], v[12:13], v[20:21]
  v_pk_add_f32 v[14:15], v[14:15], v[22:23]
  v_lshlrev_b32 v16, 16, v116
  v_and_b32 v17, 0xffff0000, v116
  v_lshlrev_b32 v18, 16, v117
  v_and_b32 v19, 0xffff0000, v117
  v_lshlrev_b32 v20, 16, v118
  v_and_b32 v21, 0xffff0000, v118
  v_lshlrev_b32 v22, 16, v119
  v_and_b32 v23, 0xffff0000, v119
  v_pk_add_f32 v[8:9], v[8:9], v[16:17]
  v_pk_add_f32 v[10:11], v[10:11], v[18:19]
  v_pk_add_f32 v[12:13], v[12:13], v[20:21]
  v_pk_add_f32 v[14:15], v[14:15], v[22:23]
  s_waitcnt vmcnt(4)
  v_lshlrev_b32 v16, 16, v120
  v_and_b32 v17, 0xffff0000, v120
  v_lshlrev_b32 v18, 16, v121
  v_and_b32 v19, 0xffff0000, v121
  v_lshlrev_b32 v20, 16, v122
  v_and_b32 v21, 0xffff0000, v122
  v_lshlrev_b32 v22, 16, v123
  v_and_b32 v23, 0xffff0000, v123
  v_pk_add_f32 v[8:9], v[8:9], v[16:17]
  v_pk_add_f32 v[10:11], v[10:11], v[18:19]
  v_pk_add_f32 v[12:13], v[12:13], v[20:21]
  v_pk_add_f32 v[14:15], v[14:15], v[22:23]
  v_lshlrev_b32 v16, 16, v124
  v_and_b32 v17, 0xffff0000, v124
  v_lshlrev_b32 v18, 16, v125
  v_and_b32 v19, 0xffff0000, v125
  v_lshlrev_b32 v20, 16, v126
  v_and_b32 v21, 0xffff0000, v126
  v_lshlrev_b32 v22, 16, v127
  v_and_b32 v23, 0xffff0000, v127
  v_pk_add_f32 v[8:9], v[8:9], v[16:17]
  v_pk_add_f32 v[10:11], v[10:11], v[18:19]
  v_pk_add_f32 v[12:13], v[12:13], v[20:21]
  v_pk_add_f32 v[14:15], v[14:15], v[22:23]
  v_lshlrev_b32 v16, 16, v128
  v_and_b32 v17, 0xffff0000, v128
  v_lshlrev_b32 v18, 16, v129
  v_and_b32 v19, 0xffff0000, v129
  v_lshlrev_b32 v20, 16, v130
  v_and_b32 v21, 0xffff0000, v130
  v_lshlrev_b32 v22, 16, v131
  v_and_b32 v23, 0xffff0000, v131
  v_pk_add_f32 v[8:9], v[8:9], v[16:17]
  v_pk_add_f32 v[10:11], v[10:11], v[18:19]
  v_pk_add_f32 v[12:13], v[12:13], v[20:21]
  v_pk_add_f32 v[14:15], v[14:15], v[22:23]
  v_lshlrev_b32 v16, 16, v132
  v_and_b32 v17, 0xffff0000, v132
  v_lshlrev_b32 v18, 16, v133
  v_and_b32 v19, 0xffff0000, v133
  v_lshlrev_b32 v20, 16, v134
  v_and_b32 v21, 0xffff0000, v134
  v_lshlrev_b32 v22, 16, v135
  v_and_b32 v23, 0xffff0000, v135
  v_pk_add_f32 v[8:9], v[8:9], v[16:17]
  v_pk_add_f32 v[10:11], v[10:11], v[18:19]
  v_pk_add_f32 v[12:13], v[12:13], v[20:21]
  v_pk_add_f32 v[14:15], v[14:15], v[22:23]
  s_waitcnt vmcnt(0)
  v_lshlrev_b32 v16, 16, v136
  v_and_b32 v17, 0xffff0000, v136
  v_lshlrev_b32 v18, 16, v137
  v_and_b32 v19, 0xffff0000, v137
  v_lshlrev_b32 v20, 16, v138
  v_and_b32 v21, 0xffff0000, v138
  v_lshlrev_b32 v22, 16, v139
  v_and_b32 v23, 0xffff0000, v139
  v_pk_add_f32 v[8:9], v[8:9], v[16:17]
  v_pk_add_f32 v[10:11], v[10:11], v[18:19]
  v_pk_add_f32 v[12:13], v[12:13], v[20:21]
  v_pk_add_f32 v[14:15], v[14:15], v[22:23]
  v_lshlrev_b32 v16, 16, v140
  v_and_b32 v17, 0xffff0000, v140
  v_lshlrev_b32 v18, 16, v141
  v_and_b32 v19, 0xffff0000, v141
  v_lshlrev_b32 v20, 16, v142
  v_and_b32 v21, 0xffff0000, v142
  v_lshlrev_b32 v22, 16, v143
  v_and_b32 v23, 0xffff0000, v143
  v_pk_add_f32 v[8:9], v[8:9], v[16:17]
  v_pk_add_f32 v[10:11], v[10:11], v[18:19]
  v_pk_add_f32 v[12:13], v[12:13], v[20:21]
  v_pk_add_f32 v[14:15], v[14:15], v[22:23]
  v_lshlrev_b32 v16, 16, v144
  v_and_b32 v17, 0xffff0000, v144
  v_lshlrev_b32 v18, 16, v145
  v_and_b32 v19, 0xffff0000, v145
  v_lshlrev_b32 v20, 16, v146
  v_and_b32 v21, 0xffff0000, v146
  v_lshlrev_b32 v22, 16, v147
  v_and_b32 v23, 0xffff0000, v147
  v_pk_add_f32 v[8:9], v[8:9], v[16:17]
  v_pk_add_f32 v[10:11], v[10:11], v[18:19]
  v_pk_add_f32 v[12:13], v[12:13], v[20:21]
  v_pk_add_f32 v[14:15], v[14:15], v[22:23]
  v_lshlrev_b32 v16, 16, v148
  v_and_b32 v17, 0xffff0000, v148
  v_lshlrev_b32 v18, 16, v149
  v_and_b32 v19, 0xffff0000, v149
  v_lshlrev_b32 v20, 16, v150
  v_and_b32 v21, 0xffff0000, v150
  v_lshlrev_b32 v22, 16, v151
  v_and_b32 v23, 0xffff0000, v151
  v_pk_add_f32 v[8:9], v[8:9], v[16:17]
  v_pk_add_f32 v[10:11], v[10:11], v[18:19]
  v_pk_add_f32 v[12:13], v[12:13], v[20:21]
  v_pk_add_f32 v[14:15], v[14:15], v[22:23]
  s_mov_b64 exec, s[48:49]
  s_nop 1
  v_permlane32_swap_b32 v8, v9
  v_permlane32_swap_b32 v10, v11
  v_permlane32_swap_b32 v12, v13
  v_permlane32_swap_b32 v14, v15
  s_nop 0
  v_add_f32 v8, v8, v9
  v_add_f32 v10, v10, v11
  v_add_f32 v12, v12, v13
  v_add_f32 v14, v14, v15
  s_nop 1
  v_permlane16_swap_b32 v8, v10
  v_permlane16_swap_b32 v12, v14
  s_nop 0
  v_add_f32 v8, v8, v10
  v_add_f32 v12, v12, v14
  s_and_b32 exec_lo, s48, 0x0fff0fff
  s_and_b32 exec_hi, s49, 0x0fff0fff
  s_cbranch_execz L_aret
  ds_write_b32 v5, v8
  ds_write_b32 v5, v12 offset:16
  s_waitcnt lgkmcnt(0)
  s_barrier
  s_barrier
L_s2:
  ds_read_b128 v[8:11], v4 offset:3072
  ds_read_b128 v[12:15], v4 offset:3088
  s_waitcnt lgkmcnt(0)
  v_lshlrev_b32 v16, 16, v24
  v_and_b32 v17, 0xffff0000, v24
  v_lshlrev_b32 v18, 16, v25
  v_and_b32 v19, 0xffff0000, v25
  v_lshlrev_b32 v20, 16, v26
  v_and_b32 v21, 0xffff0000, v26
  v_lshlrev_b32 v22, 16, v27
  v_and_b32 v23, 0xffff0000, v27
  v_pk_mul_f32 v[16:17], v[16:17], v[8:9]
  v_pk_mul_f32 v[18:19], v[18:19], v[10:11]
  v_pk_mul_f32 v[20:21], v[20:21], v[12:13]
  v_pk_mul_f32 v[22:23], v[22:23], v[14:15]
  v_cvt_pk_bf16_f32 v24, v16, v17
  v_cvt_pk_bf16_f32 v25, v18, v19
  v_cvt_pk_bf16_f32 v26, v20, v21
  v_cvt_pk_bf16_f32 v27, v22, v23
  s_mov_b32 s40, 0
  s_cbranch_execz L_k1
  buffer_store_dwordx4 v[24:27], v1, s[20:23], s40 offen offset:0 sc0 sc1
L_k1:
  v_lshlrev_b32 v16, 16, v28
  v_and_b32 v17, 0xffff0000, v28
  v_lshlrev_b32 v18, 16, v29
  v_and_b32 v19, 0xffff0000, v29
  v_lshlrev_b32 v20, 16, v30
  v_and_b32 v21, 0xffff0000, v30
  v_lshlrev_b32 v22, 16, v31
  v_and_b32 v23, 0xffff0000, v31
  v_pk_mul_f32 v[16:17], v[16:17], v[8:9]
  v_pk_mul_f32 v[18:19], v[18:19], v[10:11]
  v_pk_mul_f32 v[20:21], v[20:21], v[12:13]
  v_pk_mul_f32 v[22:23], v[22:23], v[14:15]
  v_cvt_pk_bf16_f32 v28, v16, v17
  v_cvt_pk_bf16_f32 v29, v18, v19
  v_cvt_pk_bf16_f32 v30, v20, v21
  v_cvt_pk_bf16_f32 v31, v22, v23
  s_cbranch_execz L_k2
  buffer_store_dwordx4 v[28:31], v1, s[20:23], s40 offen offset:768 sc0 sc1
L_k2:
  v_lshlrev_b32 v16, 16, v32
  v_and_b32 v17, 0xffff0000, v32
  v_lshlrev_b32 v18, 16, v33
  v_and_b32 v19, 0xffff0000, v33
  v_lshlrev_b32 v20, 16, v34
  v_and_b32 v21, 0xffff0000, v34
  v_lshlrev_b32 v22, 16, v35
  v_and_b32 v23, 0xffff0000, v35
  v_pk_mul_f32 v[16:17], v[16:17], v[8:9]
  v_pk_mul_f32 v[18:19], v[18:19], v[10:11]
  v_pk_mul_f32 v[20:21], v[20:21], v[12:13]
  v_pk_mul_f32 v[22:23], v[22:23], v[14:15]
  v_cvt_pk_bf16_f32 v32, v16, v17
  v_cvt_pk_bf16_f32 v33, v18, v19
  v_cvt_pk_bf16_f32 v34, v20, v21
  v_cvt_pk_bf16_f32 v35, v22, v23
  s_cbranch_execz L_k3
  buffer_store_dwordx4 v[32:35], v1, s[20:23], s40 offen offset:1536 sc0 sc1
L_k3:
  v_lshlrev_b32 v16, 16, v36
  v_and_b32 v17, 0xffff0000, v36
  v_lshlrev_b32 v18, 16, v37
  v_and_b32 v19, 0xffff0000, v37
  v_lshlrev_b32 v20, 16, v38
  v_and_b32 v21, 0xffff0000, v38
  v_lshlrev_b32 v22, 16, v39
  v_and_b32 v23, 0xffff0000, v39
  v_pk_mul_f32 v[16:17], v[16:17], v[8:9]
  v_pk_mul_f32 v[18:19], v[18:19], v[10:11]
  v_pk_mul_f32 v[20:21], v[20:21], v[12:13]
  v_pk_mul_f32 v[22:23], v[22:23], v[14:15]
  v_cvt_pk_bf16_f32 v36, v16, v17
  v_cvt_pk_bf16_f32 v37, v18, v19
  v_cvt_pk_bf16_f32 v38, v20, v21
  v_cvt_pk_bf16_f32 v39, v22, v23
  s_cbranch_execz L_k4
  buffer_store_dwordx4 v[36:39], v1, s[20:23], s40 offen offset:2304 sc0 sc1
L_k4:
  v_lshlrev_b32 v16, 16, v40
  v_and_b32 v17, 0xffff0000, v40
  v_lshlrev_b32 v18, 16, v41
  v_and_b32 v19, 0xffff0000, v41
  v_lshlrev_b32 v20, 16, v42
  v_and_b32 v21, 0xffff0000, v42
  v_lshlrev_b32 v22, 16, v43
  v_and_b32 v23, 0xffff0000, v43
  v_pk_mul_f32 v[16:17], v[16:17], v[8:9]
  v_pk_mul_f32 v[18:19], v[18:19], v[10:11]
  v_pk_mul_f32 v[20:21], v[20:21], v[12:13]
  v_pk_mul_f32 v[22:23], v[22:23], v[14:15]
  v_cvt_pk_bf16_f32 v40, v16, v17
  v_cvt_pk_bf16_f32 v41, v18, v19
  v_cvt_pk_bf16_f32 v42, v20, v21
  v_cvt_pk_bf16_f32 v43, v22, v23
  s_add_u32 s40, s40, 24576
  s_cbranch_execz L_k5
  buffer_store_dwordx4 v[40:43], v1, s[20:23], s40 offen offset:0 sc0 sc1
L_k5:
  v_lshlrev_b32 v16, 16, v44
  v_and_b32 v17, 0xffff0000, v44
  v_lshlrev_b32 v18, 16, v45
  v_and_b32 v19, 0xffff0000, v45
  v_lshlrev_b32 v20, 16, v46
  v_and_b32 v21, 0xffff0000, v46
  v_lshlrev_b32 v22, 16, v47
  v_and_b32 v23, 0xffff0000, v47
  v_pk_mul_f32 v[16:17], v[16:17], v[8:9]
  v_pk_mul_f32 v[18:19], v[18:19], v[10:11]
  v_pk_mul_f32 v[20:21], v[20:21], v[12:13]
  v_pk_mul_f32 v[22:23], v[22:23], v[14:15]
  v_cvt_pk_bf16_f32 v44, v16, v17
  v_cvt_pk_bf16_f32 v45, v18, v19
  v_cvt_pk_bf16_f32 v46, v20, v21
  v_cvt_pk_bf16_f32 v47, v22, v23
  s_cbranch_execz L_k6
  buffer_store_dwordx4 v[44:47], v1, s[20:23], s40 offen offset:768 sc0 sc1
L_k6:
  v_lshlrev_b32 v16, 16, v48
  v_and_b32 v17, 0xffff0000, v48
  v_lshlrev_b32 v18, 16, v49
  v_and_b32 v19, 0xffff0000, v49
  v_lshlrev_b32 v20, 16, v50
  v_and_b32 v21, 0xffff0000, v50
  v_lshlrev_b32 v22, 16, v51
  v_and_b32 v23, 0xffff0000, v51
  v_pk_mul_f32 v[16:17], v[16:17], v[8:9]
  v_pk_mul_f32 v[18:19], v[18:19], v[10:11]
  v_pk_mul_f32 v[20:21], v[20:21], v[12:13]
  v_pk_mul_f32 v[22:23], v[22:23], v[14:15]
  v_cvt_pk_bf16_f32 v48, v16, v17
  v_cvt_pk_bf16_f32 v49, v18, v19
  v_cvt_pk_bf16_f32 v50, v20, v21
  v_cvt_pk_bf16_f32 v51, v22, v23
  s_cbranch_execz L_k7
  buffer_store_dwordx4 v[48:51], v1, s[20:23], s40 offen offset:1536 sc0 sc1
L_k7:
  v_lshlrev_b32 v16, 16, v52
  v_and_b32 v17, 0xffff0000, v52
  v_lshlrev_b32 v18, 16, v53
  v_and_b32 v19, 0xffff0000, v53
  v_lshlrev_b32 v20, 16, v54
  v_and_b32 v21, 0xffff0000, v54
  v_lshlrev_b32 v22, 16, v55
  v_and_b32 v23, 0xffff0000, v55
  v_pk_mul_f32 v[16:17], v[16:17], v[8:9]
  v_pk_mul_f32 v[18:19], v[18:19], v[10:11]
  v_pk_mul_f32 v[20:21], v[20:21], v[12:13]
  v_pk_mul_f32 v[22:23], v[22:23], v[14:15]
  v_cvt_pk_bf16_f32 v52, v16, v17
  v_cvt_pk_bf16_f32 v53, v18, v19
  v_cvt_pk_bf16_f32 v54, v20, v21
  v_cvt_pk_bf16_f32 v55, v22, v23
  s_cbranch_execz L_k8
  buffer_store_dwordx4 v[52:55], v1, s[20:23], s40 offen offset:2304 sc0 sc1
L_k8:
  v_lshlrev_b32 v16, 16, v56
  v_and_b32 v17, 0xffff0000, v56
  v_lshlrev_b32 v18, 16, v57
  v_and_b32 v19, 0xffff0000, v57
  v_lshlrev_b32 v20, 16, v58
  v_and_b32 v21, 0xffff0000, v58
  v_lshlrev_b32 v22, 16, v59
  v_and_b32 v23, 0xffff0000, v59
  v_pk_mul_f32 v[16:17], v[16:17], v[8:9]
  v_pk_mul_f32 v[18:19], v[18:19], v[10:11]
  v_pk_mul_f32 v[20:21], v[20:21], v[12:13]
  v_pk_mul_f32 v[22:23], v[22:23], v[14:15]
  v_cvt_pk_bf16_f32 v56, v16, v17
  v_cvt_pk_bf16_f32 v57, v18, v19
  v_cvt_pk_bf16_f32 v58, v20, v21
  v_cvt_pk_bf16_f32 v59, v22, v23
  s_add_u32 s40, s40, 24576
  s_cbranch_execz L_k9
  buffer_store_dwordx4 v[56:59], v1, s[20:23], s40 offen offset:0 sc0 sc1
L_k9:
  v_lshlrev_b32 v16, 16, v60
  v_and_b32 v17, 0xffff0000, v60
  v_lshlrev_b32 v18, 16, v61
  v_and_b32 v19, 0xffff0000, v61
  v_lshlrev_b32 v20, 16, v62
  v_and_b32 v21, 0xffff0000, v62
  v_lshlrev_b32 v22, 16, v63
  v_and_b32 v23, 0xffff0000, v63
  v_pk_mul_f32 v[16:17], v[16:17], v[8:9]
  v_pk_mul_f32 v[18:19], v[18:19], v[10:11]
  v_pk_mul_f32 v[20:21], v[20:21], v[12:13]
  v_pk_mul_f32 v[22:23], v[22:23], v[14:15]
  v_cvt_pk_bf16_f32 v60, v16, v17
  v_cvt_pk_bf16_f32 v61, v18, v19
  v_cvt_pk_bf16_f32 v62, v20, v21
  v_cvt_pk_bf16_f32 v63, v22, v23
  s_cbranch_execz L_k10
  buffer_store_dwordx4 v[60:63], v1, s[20:23], s40 offen offset:768 sc0 sc1
L_k10:
  v_lshlrev_b32 v16, 16, v64
  v_and_b32 v17, 0xffff0000, v64
  v_lshlrev_b32 v18, 16, v65
  v_and_b32 v19, 0xffff0000, v65
  v_lshlrev_b32 v20, 16, v66
  v_and_b32 v21, 0xffff0000, v66
  v_lshlrev_b32 v22, 16, v67
  v_and_b32 v23, 0xffff0000, v67
  v_pk_mul_f32 v[16:17], v[16:17], v[8:9]
  v_pk_mul_f32 v[18:19], v[18:19], v[10:11]
  v_pk_mul_f32 v[20:21], v[20:21], v[12:13]
  v_pk_mul_f32 v[22:23], v[22:23], v[14:15]
  v_cvt_pk_bf16_f32 v64, v16, v17
  v_cvt_pk_bf16_f32 v65, v18, v19
  v_cvt_pk_bf16_f32 v66, v20, v21
  v_cvt_pk_bf16_f32 v67, v22, v23
  s_cbranch_execz L_k11
  buffer_store_dwordx4 v[64:67], v1, s[20:23], s40 offen offset:1536 sc0 sc1
L_k11:
  v_lshlrev_b32 v16, 16, v68
  v_and_b32 v17, 0xffff0000, v68
  v_lshlrev_b32 v18, 16, v69
  v_and_b32 v19, 0xffff0000, v69
  v_lshlrev_b32 v20, 16, v70
  v_and_b32 v21, 0xffff0000, v70
  v_lshlrev_b32 v22, 16, v71
  v_and_b32 v23, 0xffff0000, v71
  v_pk_mul_f32 v[16:17], v[16:17], v[8:9]
  v_pk_mul_f32 v[18:19], v[18:19], v[10:11]
  v_pk_mul_f32 v[20:21], v[20:21], v[12:13]
  v_pk_mul_f32 v[22:23], v[22:23], v[14:15]
  v_cvt_pk_bf16_f32 v68, v16, v17
  v_cvt_pk_bf16_f32 v69, v18, v19
  v_cvt_pk_bf16_f32 v70, v20, v21
  v_cvt_pk_bf16_f32 v71, v22, v23
  s_cbranch_execz L_k12
  buffer_store_dwordx4 v[68:71], v1, s[20:23], s40 offen offset:2304 sc0 sc1
L_k12:
  v_lshlrev_b32 v16, 16, v72
  v_and_b32 v17, 0xffff0000, v72
  v_lshlrev_b32 v18, 16, v73
  v_and_b32 v19, 0xffff0000, v73
  v_lshlrev_b32 v20, 16, v74
  v_and_b32 v21, 0xffff0000, v74
  v_lshlrev_b32 v22, 16, v75
  v_and_b32 v23, 0xffff0000, v75
  v_pk_mul_f32 v[16:17], v[16:17], v[8:9]
  v_pk_mul_f32 v[18:19], v[18:19], v[10:11]
  v_pk_mul_f32 v[20:21], v[20:21], v[12:13]
  v_pk_mul_f32 v[22:23], v[22:23], v[14:15]
  v_cvt_pk_bf16_f32 v72, v16, v17
  v_cvt_pk_bf16_f32 v73, v18, v19
  v_cvt_pk_bf16_f32 v74, v20, v21
  v_cvt_pk_bf16_f32 v75, v22, v23
  s_add_u32 s40, s40, 24576
  s_cbranch_execz L_k13
  buffer_store_dwordx4 v[72:75], v1, s[20:23], s40 offen offset:0 sc0 sc1
L_k13:
  v_lshlrev_b32 v16, 16, v76
  v_and_b32 v17, 0xffff0000, v76
  v_lshlrev_b32 v18, 16, v77
  v_and_b32 v19, 0xffff0000, v77
  v_lshlrev_b32 v20, 16, v78
  v_and_b32 v21, 0xffff0000, v78
  v_lshlrev_b32 v22, 16, v79
  v_and_b32 v23, 0xffff0000, v79
  v_pk_mul_f32 v[16:17], v[16:17], v[8:9]
  v_pk_mul_f32 v[18:19], v[18:19], v[10:11]
  v_pk_mul_f32 v[20:21], v[20:21], v[12:13]
  v_pk_mul_f32 v[22:23], v[22:23], v[14:15]
  v_cvt_pk_bf16_f32 v76, v16, v17
  v_cvt_pk_bf16_f32 v77, v18, v19
  v_cvt_pk_bf16_f32 v78, v20, v21
  v_cvt_pk_bf16_f32 v79, v22, v23
  s_cbranch_execz L_k14
  buffer_store_dwordx4 v[76:79], v1, s[20:23], s40 offen offset:768 sc0 sc1
L_k14:
  v_lshlrev_b32 v16, 16, v80
  v_and_b32 v17, 0xffff0000, v80
  v_lshlrev_b32 v18, 16, v81
  v_and_b32 v19, 0xffff0000, v81
  v_lshlrev_b32 v20, 16, v82
  v_and_b32 v21, 0xffff0000, v82
  v_lshlrev_b32 v22, 16, v83
  v_and_b32 v23, 0xffff0000, v83
  v_pk_mul_f32 v[16:17], v[16:17], v[8:9]
  v_pk_mul_f32 v[18:19], v[18:19], v[10:11]
  v_pk_mul_f32 v[20:21], v[20:21], v[12:13]
  v_pk_mul_f32 v[22:23], v[22:23], v[14:15]
  v_cvt_pk_bf16_f32 v80, v16, v17
  v_cvt_pk_bf16_f32 v81, v18, v19
  v_cvt_pk_bf16_f32 v82, v20, v21
  v_cvt_pk_bf16_f32 v83, v22, v23
  s_cbranch_execz L_k15
  buffer_store_dwordx4 v[80:83], v1, s[20:23], s40 offen offset:1536 sc0 sc1
L_k15:
  v_lshlrev_b32 v16, 16, v84
  v_and_b32 v17, 0xffff0000, v84
  v_lshlrev_b32 v18, 16, v85
  v_and_b32 v19, 0xffff0000, v85
  v_lshlrev_b32 v20, 16, v86
  v_and_b32 v21, 0xffff0000, v86
  v_lshlrev_b32 v22, 16, v87
  v_and_b32 v23, 0xffff0000, v87
  v_pk_mul_f32 v[16:17], v[16:17], v[8:9]
  v_pk_mul_f32 v[18:19], v[18:19], v[10:11]
  v_pk_mul_f32 v[20:21], v[20:21], v[12:13]
  v_pk_mul_f32 v[22:23], v[22:23], v[14:15]
  v_cvt_pk_bf16_f32 v84, v16, v17
  v_cvt_pk_bf16_f32 v85, v18, v19
  v_cvt_pk_bf16_f32 v86, v20, v21
  v_cvt_pk_bf16_f32 v87, v22, v23
  s_cbranch_execz L_k16
  buffer_store_dwordx4 v[84:87], v1, s[20:23], s40 offen offset:2304 sc0 sc1
L_k16:
  v_lshlrev_b32 v16, 16, v88
  v_and_b32 v17, 0xffff0000, v88
  v_lshlrev_b32 v18, 16, v89
  v_and_b32 v19, 0xffff0000, v89
  v_lshlrev_b32 v20, 16, v90
  v_and_b32 v21, 0xffff0000, v90
  v_lshlrev_b32 v22, 16, v91
  v_and_b32 v23, 0xffff0000, v91
  v_pk_mul_f32 v[16:17], v[16:17], v[8:9]
  v_pk_mul_f32 v[18:19], v[18:19], v[10:11]
  v_pk_mul_f32 v[20:21], v[20:21], v[12:13]
  v_pk_mul_f32 v[22:23], v[22:23], v[14:15]
  v_cvt_pk_bf16_f32 v88, v16, v17
  v_cvt_pk_bf16_f32 v89, v18, v19
  v_cvt_pk_bf16_f32 v90, v20, v21
  v_cvt_pk_bf16_f32 v91, v22, v23
  s_add_u32 s40, s40, 24576
  s_cbranch_execz L_k17
  buffer_store_dwordx4 v[88:91], v1, s[20:23], s40 offen offset:0 sc0 sc1
L_k17:
  v_lshlrev_b32 v16, 16, v92
  v_and_b32 v17, 0xffff0000, v92
  v_lshlrev_b32 v18, 16, v93
  v_and_b32 v19, 0xffff0000, v93
  v_lshlrev_b32 v20, 16, v94
  v_and_b32 v21, 0xffff0000, v94
  v_lshlrev_b32 v22, 16, v95
  v_and_b32 v23, 0xffff0000, v95
  v_pk_mul_f32 v[16:17], v[16:17], v[8:9]
  v_pk_mul_f32 v[18:19], v[18:19], v[10:11]
  v_pk_mul_f32 v[20:21], v[20:21], v[12:13]
  v_pk_mul_f32 v[22:23], v[22:23], v[14:15]
  v_cvt_pk_bf16_f32 v92, v16, v17
  v_cvt_pk_bf16_f32 v93, v18, v19
  v_cvt_pk_bf16_f32 v94, v20, v21
  v_cvt_pk_bf16_f32 v95, v22, v23
  s_cbranch_execz L_k18
  buffer_store_dwordx4 v[92:95], v1, s[20:23], s40 offen offset:768 sc0 sc1
L_k18:
  v_lshlrev_b32 v16, 16, v96
  v_and_b32 v17, 0xffff0000, v96
  v_lshlrev_b32 v18, 16, v97
  v_and_b32 v19, 0xffff0000, v97
  v_lshlrev_b32 v20, 16, v98
  v_and_b32 v21, 0xffff0000, v98
  v_lshlrev_b32 v22, 16, v99
  v_and_b32 v23, 0xffff0000, v99
  v_pk_mul_f32 v[16:17], v[16:17], v[8:9]
  v_pk_mul_f32 v[18:19], v[18:19], v[10:11]
  v_pk_mul_f32 v[20:21], v[20:21], v[12:13]
  v_pk_mul_f32 v[22:23], v[22:23], v[14:15]
  v_cvt_pk_bf16_f32 v96, v16, v17
  v_cvt_pk_bf16_f32 v97, v18, v19
  v_cvt_pk_bf16_f32 v98, v20, v21
  v_cvt_pk_bf16_f32 v99, v22, v23
  s_cbranch_execz L_k19
  buffer_store_dwordx4 v[96:99], v1, s[20:23], s40 offen offset:1536 sc0 sc1
L_k19:
  v_lshlrev_b32 v16, 16, v100
  v_and_b32 v17, 0xffff0000, v100
  v_lshlrev_b32 v18, 16, v101
  v_and_b32 v19, 0xffff0000, v101
  v_lshlrev_b32 v20, 16, v102
  v_and_b32 v21, 0xffff0000, v102
  v_lshlrev_b32 v22, 16, v103
  v_and_b32 v23, 0xffff0000, v103
  v_pk_mul_f32 v[16:17], v[16:17], v[8:9]
  v_pk_mul_f32 v[18:19], v[18:19], v[10:11]
  v_pk_mul_f32 v[20:21], v[20:21], v[12:13]
  v_pk_mul_f32 v[22:23], v[22:23], v[14:15]
  v_cvt_pk_bf16_f32 v100, v16, v17
  v_cvt_pk_bf16_f32 v101, v18, v19
  v_cvt_pk_bf16_f32 v102, v20, v21
  v_cvt_pk_bf16_f32 v103, v22, v23
  s_cbranch_execz L_k20
  buffer_store_dwordx4 v[100:103], v1, s[20:23], s40 offen offset:2304 sc0 sc1
L_k20:
  v_lshlrev_b32 v16, 16, v104
  v_and_b32 v17, 0xffff0000, v104
  v_lshlrev_b32 v18, 16, v105
  v_and_b32 v19, 0xffff0000, v105
  v_lshlrev_b32 v20, 16, v106
  v_and_b32 v21, 0xffff0000, v106
  v_lshlrev_b32 v22, 16, v107
  v_and_b32 v23, 0xffff0000, v107
  v_pk_mul_f32 v[16:17], v[16:17], v[8:9]
  v_pk_mul_f32 v[18:19], v[18:19], v[10:11]
  v_pk_mul_f32 v[20:21], v[20:21], v[12:13]
  v_pk_mul_f32 v[22:23], v[22:23], v[14:15]
  v_cvt_pk_bf16_f32 v104, v16, v17
  v_cvt_pk_bf16_f32 v105, v18, v19
  v_cvt_pk_bf16_f32 v106, v20, v21
  v_cvt_pk_bf16_f32 v107, v22, v23
  s_add_u32 s40, s40, 24576
  s_cbranch_execz L_k21
  buffer_store_dwordx4 v[104:107], v1, s[20:23], s40 offen offset:0 sc0 sc1
L_k21:
  v_lshlrev_b32 v16, 16, v108
  v_and_b32 v17, 0xffff0000, v108
  v_lshlrev_b32 v18, 16, v109
  v_and_b32 v19, 0xffff0000, v109
  v_lshlrev_b32 v20, 16, v110
  v_and_b32 v21, 0xffff0000, v110
  v_lshlrev_b32 v22, 16, v111
  v_and_b32 v23, 0xffff0000, v111
  v_pk_mul_f32 v[16:17], v[16:17], v[8:9]
  v_pk_mul_f32 v[18:19], v[18:19], v[10:11]
  v_pk_mul_f32 v[20:21], v[20:21], v[12:13]
  v_pk_mul_f32 v[22:23], v[22:23], v[14:15]
  v_cvt_pk_bf16_f32 v108, v16, v17
  v_cvt_pk_bf16_f32 v109, v18, v19
  v_cvt_pk_bf16_f32 v110, v20, v21
  v_cvt_pk_bf16_f32 v111, v22, v23
  s_cbranch_execz L_k22
  buffer_store_dwordx4 v[108:111], v1, s[20:23], s40 offen offset:768 sc0 sc1
L_k22:
  v_lshlrev_b32 v16, 16, v112
  v_and_b32 v17, 0xffff0000, v112
  v_lshlrev_b32 v18, 16, v113
  v_and_b32 v19, 0xffff0000, v113
  v_lshlrev_b32 v20, 16, v114
  v_and_b32 v21, 0xffff0000, v114
  v_lshlrev_b32 v22, 16, v115
  v_and_b32 v23, 0xffff0000, v115
  v_pk_mul_f32 v[16:17], v[16:17], v[8:9]
  v_pk_mul_f32 v[18:19], v[18:19], v[10:11]
  v_pk_mul_f32 v[20:21], v[20:21], v[12:13]
  v_pk_mul_f32 v[22:23], v[22:23], v[14:15]
  v_cvt_pk_bf16_f32 v112, v16, v17
  v_cvt_pk_bf16_f32 v113, v18, v19
  v_cvt_pk_bf16_f32 v114, v20, v21
  v_cvt_pk_bf16_f32 v115, v22, v23
  s_cbranch_execz L_k23
  buffer_store_dwordx4 v[112:115], v1, s[20:23], s40 offen offset:1536 sc0 sc1
L_k23:
  v_lshlrev_b32 v16, 16, v116
  v_and_b32 v17, 0xffff0000, v116
  v_lshlrev_b32 v18, 16, v117
  v_and_b32 v19, 0xffff0000, v117
  v_lshlrev_b32 v20, 16, v118
  v_and_b32 v21, 0xffff0000, v118
  v_lshlrev_b32 v22, 16, v119
  v_and_b32 v23, 0xffff0000, v119
  v_pk_mul_f32 v[16:17], v[16:17], v[8:9]
  v_pk_mul_f32 v[18:19], v[18:19], v[10:11]
  v_pk_mul_f32 v[20:21], v[20:21], v[12:13]
  v_pk_mul_f32 v[22:23], v[22:23], v[14:15]
  v_cvt_pk_bf16_f32 v116, v16, v17
  v_cvt_pk_bf16_f32 v117, v18, v19
  v_cvt_pk_bf16_f32 v118, v20, v21
  v_cvt_pk_bf16_f32 v119, v22, v23
  s_cbranch_execz L_k24
  buffer_store_dwordx4 v[116:119], v1, s[20:23], s40 offen offset:2304 sc0 sc1
L_k24:
  v_lshlrev_b32 v16, 16, v120
  v_and_b32 v17, 0xffff0000, v120
  v_lshlrev_b32 v18, 16, v121
  v_and_b32 v19, 0xffff0000, v121
  v_lshlrev_b32 v20, 16, v122
  v_and_b32 v21, 0xffff0000, v122
  v_lshlrev_b32 v22, 16, v123
  v_and_b32 v23, 0xffff0000, v123
  v_pk_mul_f32 v[16:17], v[16:17], v[8:9]
  v_pk_mul_f32 v[18:19], v[18:19], v[10:11]
  v_pk_mul_f32 v[20:21], v[20:21], v[12:13]
  v_pk_mul_f32 v[22:23], v[22:23], v[14:15]
  v_cvt_pk_bf16_f32 v120, v16, v17
  v_cvt_pk_bf16_f32 v121, v18, v19
  v_cvt_pk_bf16_f32 v122, v20, v21
  v_cvt_pk_bf16_f32 v123, v22, v23
  s_add_u32 s40, s40, 24576
  s_cbranch_execz L_k25
  buffer_store_dwordx4 v[120:123], v1, s[20:23], s40 offen offset:0 sc0 sc1
L_k25:
  v_lshlrev_b32 v16, 16, v124
  v_and_b32 v17, 0xffff0000, v124
  v_lshlrev_b32 v18, 16, v125
  v_and_b32 v19, 0xffff0000, v125
  v_lshlrev_b32 v20, 16, v126
  v_and_b32 v21, 0xffff0000, v126
  v_lshlrev_b32 v22, 16, v127
  v_and_b32 v23, 0xffff0000, v127
  v_pk_mul_f32 v[16:17], v[16:17], v[8:9]
  v_pk_mul_f32 v[18:19], v[18:19], v[10:11]
  v_pk_mul_f32 v[20:21], v[20:21], v[12:13]
  v_pk_mul_f32 v[22:23], v[22:23], v[14:15]
  v_cvt_pk_bf16_f32 v124, v16, v17
  v_cvt_pk_bf16_f32 v125, v18, v19
  v_cvt_pk_bf16_f32 v126, v20, v21
  v_cvt_pk_bf16_f32 v127, v22, v23
  s_cbranch_execz L_k26
  buffer_store_dwordx4 v[124:127], v1, s[20:23], s40 offen offset:768 sc0 sc1
L_k26:
  v_lshlrev_b32 v16, 16, v128
  v_and_b32 v17, 0xffff0000, v128
  v_lshlrev_b32 v18, 16, v129
  v_and_b32 v19, 0xffff0000, v129
  v_lshlrev_b32 v20, 16, v130
  v_and_b32 v21, 0xffff0000, v130
  v_lshlrev_b32 v22, 16, v131
  v_and_b32 v23, 0xffff0000, v131
  v_pk_mul_f32 v[16:17], v[16:17], v[8:9]
  v_pk_mul_f32 v[18:19], v[18:19], v[10:11]
  v_pk_mul_f32 v[20:21], v[20:21], v[12:13]
  v_pk_mul_f32 v[22:23], v[22:23], v[14:15]
  v_cvt_pk_bf16_f32 v128, v16, v17
  v_cvt_pk_bf16_f32 v129, v18, v19
  v_cvt_pk_bf16_f32 v130, v20, v21
  v_cvt_pk_bf16_f32 v131, v22, v23
  s_cbranch_execz L_k27
  buffer_store_dwordx4 v[128:131], v1, s[20:23], s40 offen offset:1536 sc0 sc1
L_k27:
  v_lshlrev_b32 v16, 16, v132
  v_and_b32 v17, 0xffff0000, v132
  v_lshlrev_b32 v18, 16, v133
  v_and_b32 v19, 0xffff0000, v133
  v_lshlrev_b32 v20, 16, v134
  v_and_b32 v21, 0xffff0000, v134
  v_lshlrev_b32 v22, 16, v135
  v_and_b32 v23, 0xffff0000, v135
  v_pk_mul_f32 v[16:17], v[16:17], v[8:9]
  v_pk_mul_f32 v[18:19], v[18:19], v[10:11]
  v_pk_mul_f32 v[20:21], v[20:21], v[12:13]
  v_pk_mul_f32 v[22:23], v[22:23], v[14:15]
  v_cvt_pk_bf16_f32 v132, v16, v17
  v_cvt_pk_bf16_f32 v133, v18, v19
  v_cvt_pk_bf16_f32 v134, v20, v21
  v_cvt_pk_bf16_f32 v135, v22, v23
  s_cbranch_execz L_k28
  buffer_store_dwordx4 v[132:135], v1, s[20:23], s40 offen offset:2304 sc0 sc1
L_k28:
  v_lshlrev_b32 v16, 16, v136
  v_and_b32 v17, 0xffff0000, v136
  v_lshlrev_b32 v18, 16, v137
  v_and_b32 v19, 0xffff0000, v137
  v_lshlrev_b32 v20, 16, v138
  v_and_b32 v21, 0xffff0000, v138
  v_lshlrev_b32 v22, 16, v139
  v_and_b32 v23, 0xffff0000, v139
  v_pk_mul_f32 v[16:17], v[16:17], v[8:9]
  v_pk_mul_f32 v[18:19], v[18:19], v[10:11]
  v_pk_mul_f32 v[20:21], v[20:21], v[12:13]
  v_pk_mul_f32 v[22:23], v[22:23], v[14:15]
  v_cvt_pk_bf16_f32 v136, v16, v17
  v_cvt_pk_bf16_f32 v137, v18, v19
  v_cvt_pk_bf16_f32 v138, v20, v21
  v_cvt_pk_bf16_f32 v139, v22, v23
  s_add_u32 s40, s40, 24576
  s_cbranch_execz L_k29
  buffer_store_dwordx4 v[136:139], v1, s[20:23], s40 offen offset:0 sc0 sc1
L_k29:
  v_lshlrev_b32 v16, 16, v140
  v_and_b32 v17, 0xffff0000, v140
  v_lshlrev_b32 v18, 16, v141
  v_and_b32 v19, 0xffff0000, v141
  v_lshlrev_b32 v20, 16, v142
  v_and_b32 v21, 0xffff0000, v142
  v_lshlrev_b32 v22, 16, v143
  v_and_b32 v23, 0xffff0000, v143
  v_pk_mul_f32 v[16:17], v[16:17], v[8:9]
  v_pk_mul_f32 v[18:19], v[18:19], v[10:11]
  v_pk_mul_f32 v[20:21], v[20:21], v[12:13]
  v_pk_mul_f32 v[22:23], v[22:23], v[14:15]
  v_cvt_pk_bf16_f32 v140, v16, v17
  v_cvt_pk_bf16_f32 v141, v18, v19
  v_cvt_pk_bf16_f32 v142, v20, v21
  v_cvt_pk_bf16_f32 v143, v22, v23
  s_cbranch_execz L_k30
  buffer_store_dwordx4 v[140:143], v1, s[20:23], s40 offen offset:768 sc0 sc1
L_k30:
  v_lshlrev_b32 v16, 16, v144
  v_and_b32 v17, 0xffff0000, v144
  v_lshlrev_b32 v18, 16, v145
  v_and_b32 v19, 0xffff0000, v145
  v_lshlrev_b32 v20, 16, v146
  v_and_b32 v21, 0xffff0000, v146
  v_lshlrev_b32 v22, 16, v147
  v_and_b32 v23, 0xffff0000, v147
  v_pk_mul_f32 v[16:17], v[16:17], v[8:9]
  v_pk_mul_f32 v[18:19], v[18:19], v[10:11]
  v_pk_mul_f32 v[20:21], v[20:21], v[12:13]
  v_pk_mul_f32 v[22:23], v[22:23], v[14:15]
  v_cvt_pk_bf16_f32 v144, v16, v17
  v_cvt_pk_bf16_f32 v145, v18, v19
  v_cvt_pk_bf16_f32 v146, v20, v21
  v_cvt_pk_bf16_f32 v147, v22, v23
  s_cbranch_execz L_k31
  buffer_store_dwordx4 v[144:147], v1, s[20:23], s40 offen offset:1536 sc0 sc1
L_k31:
  v_lshlrev_b32 v16, 16, v148
  v_and_b32 v17, 0xffff0000, v148
  v_lshlrev_b32 v18, 16, v149
  v_and_b32 v19, 0xffff0000, v149
  v_lshlrev_b32 v20, 16, v150
  v_and_b32 v21, 0xffff0000, v150
  v_lshlrev_b32 v22, 16, v151
  v_and_b32 v23, 0xffff0000, v151
  v_pk_mul_f32 v[16:17], v[16:17], v[8:9]
  v_pk_mul_f32 v[18:19], v[18:19], v[10:11]
  v_pk_mul_f32 v[20:21], v[20:21], v[12:13]
  v_pk_mul_f32 v[22:23], v[22:23], v[14:15]
  v_cvt_pk_bf16_f32 v148, v16, v17
  v_cvt_pk_bf16_f32 v149, v18, v19
  v_cvt_pk_bf16_f32 v150, v20, v21
  v_cvt_pk_bf16_f32 v151, v22, v23
  s_cbranch_execz L_k32
  buffer_store_dwordx4 v[148:151], v1, s[20:23], s40 offen offset:2304 sc0 sc1
L_k32:
  s_cbranch_execz L_sret
  s_endpgm
L_service:
  s_load_dwordx2 s[24:25], s[0:1], 32
  s_load_dwordx2 s[6:7], s[0:1], 8
  s_mov_b32 s22, 50331648
  s_mov_b32 s23, 0x20000
  s_mov_b64 s[48:49], 0
  s_mov_b64 exec, 0
  s_branch L_acc
L_aret:
  s_mov_b64 exec, -1
  s_mov_b32 s26, 0x200000
  s_mov_b32 s27, 0x20000
  s_lshl_b32 s4, s2, 10
  s_add_u32 s4, s4, 4096
  s_and_b32 s5, s2, 15
  s_mul_i32 s5, s5, 512
  s_add_u32 s5, s5, 266240
  v_lshlrev_b32 v20, 4, v2
  v_mul_u32_u24 v4, 16, v2
  v_lshrrev_b32 v15, 1, v2
  v_and_b32 v14, 1, v2
  v_lshlrev_b32 v15, 13, v15
  v_lshl_add_u32 v15, v14, 4, v15
  s_lshl_b32 s14, s2, 5
  s_add_u32 s14, s14, 4096
  v_add_u32 v15, s14, v15
  v_add_u32 v4, s5, v4
  v_lshlrev_b32 v13, 3, v2
  v_mov_b32 v23, 0
  s_waitcnt lgkmcnt(0)
  s_load_dwordx2 s[44:45], s[24:25], 0
  s_load_dword s8, s[6:7], 0
  s_lshl_b32 s11, s2, 13
  s_add_u32 s11, s11, 4096
  v_add_u32 v21, s11, v20
  s_movk_i32 s36, 4096
  s_mul_i32 s12, s2, 16
  s_add_u32 s12, s12, 266240
  v_mul_u32_u24 v22, 512, v2
  v_add_u32 v22, s12, v22
  s_mov_b32 s39, 32768
  s_mov_b32 s40, 65536
  s_mov_b32 s41, 98304
  s_waitcnt lgkmcnt(0)
  s_mul_i32 s46, s44, 0x9e3779b1
  s_add_u32 s46, s46, 0x7f4a7c15
  s_xor_b32 s47, s45, s46
  s_mul_i32 s47, s47, 0x85ebca6d
  s_add_u32 s47, s47, 0xc2b2ae35
  s_lshl_b32 s8, s8, 16
  v_mov_b32 v30, s46
  v_mov_b32 v31, s47
  s_mov_b64 exec, 0
  s_branch L_s2
L_sret:
  s_mov_b64 s[48:49], 0
  s_mov_b32 s10, 1
L_pass:
  s_mov_b32 exec_lo, s48
  s_and_b32 exec_hi, s49, 0xffff
  s_cmp_eq_u32 s48, 0
  s_cbranch_scc1 L_nb
  s_barrier
L_nb:
  ds_read_b64 v[32:33], v13 offset:0
  ds_read_b64 v[34:35], v13 offset:384
  ds_read_b64 v[36:37], v13 offset:768
  ds_read_b64 v[38:39], v13 offset:1152
  ds_read_b64 v[40:41], v13 offset:1536
  ds_read_b64 v[42:43], v13 offset:1920
  ds_read_b64 v[44:45], v13 offset:2304
  ds_read_b64 v[46:47], v13 offset:2688
  s_waitcnt lgkmcnt(6)
  v_pk_add_f32 v[28:29], v[32:33], v[34:35]
  s_waitcnt lgkmcnt(5)
  v_pk_add_f32 v[28:29], v[28:29], v[36:37]
  s_waitcnt lgkmcnt(4)
  v_pk_add_f32 v[28:29], v[28:29], v[38:39]
  s_waitcnt lgkmcnt(3)
  v_pk_add_f32 v[28:29], v[28:29], v[40:41]
  s_waitcnt lgkmcnt(2)
  v_pk_add_f32 v[28:29], v[28:29], v[42:43]
  s_waitcnt lgkmcnt(1)
  v_pk_add_f32 v[28:29], v[28:29], v[44:45]
  s_waitcnt lgkmcnt(0)
  v_pk_add_f32 v[28:29], v[28:29], v[46:47]
  s_cbranch_execz L_k33
  buffer_store_dwordx4 v[28:31], v15, s[24:27], 0 offen sc1
L_k33:
  s_cmp_ge_u32 s2, 24
  s_cbranch_scc1 L_mb
  s_mov_b32 s9, s10
  s_mov_b64 exec, s[48:49]
  s_cbranch_execz L_k34
  buffer_load_dwordx4 v[32:35], v21, s[24:27], 0 offen offset:0 sc1
  buffer_load_dwordx4 v[36:39], v21, s[24:27], 0 offen offset:1024 sc1
  buffer_load_dwordx4 v[40:43], v21, s[24:27], 0 offen offset:2048 sc1
  buffer_load_dwordx4 v[44:47], v21, s[24:27], 0 offen offset:3072 sc1
  buffer_load_dwordx4 v[48:51], v21, s[24:27], s36 offen offset:0 sc1
  buffer_load_dwordx4 v[52:55], v21, s[24:27], s36 offen offset:1024 sc1
  buffer_load_dwordx4 v[56:59], v21, s[24:27], s36 offen offset:2048 sc1
  buffer_load_dwordx4 v[60:63], v21, s[24:27], s36 offen offset:3072 sc1
L_k34:
  s_cbranch_execz L_k35
  buffer_load_dwordx4 v[64:67], v21, s[24:27], 0 offen offset:0 sc1
  buffer_load_dwordx4 v[68:71], v21, s[24:27], 0 offen offset:1024 sc1
  buffer_load_dwordx4 v[72:75], v21, s[24:27], 0 offen offset:2048 sc1
  buffer_load_dwordx4 v[76:79], v21, s[24:27], 0 offen offset:3072 sc1
  buffer_load_dwordx4 v[80:83], v21, s[24:27], s36 offen offset:0 sc1
  buffer_load_dwordx4 v[84:87], v21, s[24:27], s36 offen offset:1024 sc1
  buffer_load_dwordx4 v[88:91], v21, s[24:27], s36 offen offset:2048 sc1
  buffer_load_dwordx4 v[92:95], v21, s[24:27], s36 offen offset:3072 sc1
L_k35:
L_in:
  s_waitcnt vmcnt(15)
  v_cmpx_eq_u64 vcc, s[46:47], v[34:35]
  s_waitcnt vmcnt(14)
  v_cmpx_eq_u64 vcc, s[46:47], v[38:39]
  s_waitcnt vmcnt(13)
  v_cmpx_eq_u64 vcc, s[46:47], v[42:43]
  s_waitcnt vmcnt(12)
  v_cmpx_eq_u64 vcc, s[46:47], v[46:47]
  s_waitcnt vmcnt(11)
  v_cmpx_eq_u64 vcc, s[46:47], v[50:51]
  s_waitcnt vmcnt(10)
  v_cmpx_eq_u64 vcc, s[46:47], v[54:55]
  s_waitcnt vmcnt(9)
  v_cmpx_eq_u64 vcc, s[46:47], v[58:59]
  s_waitcnt vmcnt(8)
  v_cmpx_eq_u64 vcc, s[46:47], v[62:63]
  s_cmp_eq_u64 vcc, -1
  s_mov_b64 exec, s[48:49]
  s_cbranch_scc1 L_ind0
  s_cbranch_execz L_k36
  buffer_load_dwordx4 v[32:35], v21, s[24:27], 0 offen offset:0 sc1
  buffer_load_dwordx4 v[36:39], v21, s[24:27], 0 offen offset:1024 sc1
  buffer_load_dwordx4 v[40:43], v21, s[24:27], 0 offen offset:2048 sc1
  buffer_load_dwordx4 v[44:47], v21, s[24:27], 0 offen offset:3072 sc1
  buffer_load_dwordx4 v[48:51], v21, s[24:27], s36 offen offset:0 sc1
  buffer_load_dwordx4 v[52:55], v21, s[24:27], s36 offen offset:1024 sc1
  buffer_load_dwordx4 v[56:59], v21, s[24:27], s36 offen offset:2048 sc1
  buffer_load_dwordx4 v[60:63], v21, s[24:27], s36 offen offset:3072 sc1
L_k36:
  s_waitcnt vmcnt(15)
  v_cmpx_eq_u64 vcc, s[46:47], v[66:67]
  s_waitcnt vmcnt(14)
  v_cmpx_eq_u64 vcc, s[46:47], v[70:71]
  s_waitcnt vmcnt(13)
  v_cmpx_eq_u64 vcc, s[46:47], v[74:75]
  s_waitcnt vmcnt(12)
  v_cmpx_eq_u64 vcc, s[46:47], v[78:79]
  s_waitcnt vmcnt(11)
  v_cmpx_eq_u64 vcc, s[46:47], v[82:83]
  s_waitcnt vmcnt(10)
  v_cmpx_eq_u64 vcc, s[46:47], v[86:87]
  s_waitcnt vmcnt(9)
  v_cmpx_eq_u64 vcc, s[46:47], v[90:91]
  s_waitcnt vmcnt(8)
  v_cmpx_eq_u64 vcc, s[46:47], v[94:95]
  s_cmp_eq_u64 vcc, -1
  s_mov_b64 exec, s[48:49]
  s_cbranch_scc1 L_ind1
  s_cbranch_execz L_k37
  buffer_load_dwordx4 v[64:67], v21, s[24:27], 0 offen offset:0 sc1
  buffer_load_dwordx4 v[68:71], v21, s[24:27], 0 offen offset:1024 sc1
  buffer_load_dwordx4 v[72:75], v21, s[24:27], 0 offen offset:2048 sc1
  buffer_load_dwordx4 v[76:79], v21, s[24:27], 0 offen offset:3072 sc1
  buffer_load_dwordx4 v[80:83], v21, s[24:27], s36 offen offset:0 sc1
  buffer_load_dwordx4 v[84:87], v21, s[24:27], s36 offen offset:1024 sc1
  buffer_load_dwordx4 v[88:91], v21, s[24:27], s36 offen offset:2048 sc1
  buffer_load_dwordx4 v[92:95], v21, s[24:27], s36 offen offset:3072 sc1
L_k37:
  s_sub_u32 s9, s9, 1
  s_cmp_lg_u32 s9, 0
  s_cbranch_scc1 L_in
  s_waitcnt vmcnt(0)
L_ind1:
  v_pk_add_f32 v[24:25], v[64:65], v[68:69]
  v_pk_add_f32 v[24:25], v[24:25], v[72:73]
  v_pk_add_f32 v[24:25], v[24:25], v[76:77]
  v_pk_add_f32 v[24:25], v[24:25], v[80:81]
  v_pk_add_f32 v[24:25], v[24:25], v[84:85]
  v_pk_add_f32 v[24:25], v[24:25], v[88:89]
  v_pk_add_f32 v[24:25], v[24:25], v[92:93]
  s_branch L_sum
L_ind0:
  v_pk_add_f32 v[24:25], v[32:33], v[36:37]
  v_pk_add_f32 v[24:25], v[24:25], v[40:41]
  v_pk_add_f32 v[24:25], v[24:25], v[44:45]
  v_pk_add_f32 v[24:25], v[24:25], v[48:49]
  v_pk_add_f32 v[24:25], v[24:25], v[52:53]
  v_pk_add_f32 v[24:25], v[24:25], v[56:57]
  v_pk_add_f32 v[24:25], v[24:25], v[60:61]
L_sum:
  s_nop 1
  v_permlane32_swap_b32 v24, v25
  s_nop 0
  v_add_f32 v24, v24, v25
  s_nop 1
  v_add_f32_dpp v24, v24, v24 row_ror:8 row_mask:0xf bank_mask:0xf
  s_nop 1
  v_add_f32_dpp v24, v24, v24 row_ror:4 row_mask:0xf bank_mask:0xf
  s_nop 1
  v_add_f32_dpp v24, v24, v24 row_ror:2 row_mask:0xf bank_mask:0xf
  v_mov_b32 v25, v24
  s_nop 1
  v_permlane16_swap_b32 v24, v25
  s_nop 0
  v_add_f32 v24, v24, v25
  v_cvt_pk_bf16_f32 v24, v24, v24
  v_lshlrev_b32 v24, 16, v24
  v_mul_f32 v24, 0x36800000, v24
  v_cvt_pk_bf16_f32 v24, v24, v24
  v_lshlrev_b32 v24, 16, v24
  v_mul_f32 v24, s8, v24
  v_cvt_pk_bf16_f32 v24, v24, v24
  v_lshlrev_b32 v24, 16, v24
  v_mul_f32 v24, 0xbfb8aa3b, v24
  v_exp_f32 v24, v24
  s_nop 0
  v_add_f32 v24, 1.0, v24
  v_rcp_f32 v24, v24
  s_nop 0
  v_cvt_pk_bf16_f32 v24, v24, v24
  s_nop 0
  v_readlane_b32 s32, v24, 0
  v_readlane_b32 s33, v24, 32
  v_readlane_b32 s34, v24, 1
  v_readlane_b32 s35, v24, 33
  s_pack_ll_b32_b16 s32, s32, s33
  s_pack_ll_b32_b16 s34, s34, s35
  v_mov_b32 v28, s32
  v_mov_b32 v29, s34
  s_and_b64 exec, s[48:49], 65535
  s_cbranch_execz L_k38
  buffer_store_dwordx4 v[28:31], v22, s[24:27], 0 offen sc1
L_k38:
  s_cmp_lg_u32 s2, 0
  s_cbranch_scc1 L_ne
  s_and_b64 exec, s[48:49], 1
  s_cbranch_execz L_k39
  buffer_store_dwordx2 v[30:31], v23, s[24:27], 0 offen sc1
L_k39:
L_ne:
L_mb:
  s_and_b32 exec_lo, s48, 0xffffff
  s_mov_b32 exec_hi, 0
  s_mov_b32 s9, s10
  s_cbranch_execz L_k40
  buffer_load_dwordx4 v[128:131], v4, s[24:27], 0 offen sc1
L_k40:
  s_cbranch_execz L_k41
  buffer_load_dwordx4 v[132:135], v4, s[24:27], 0 offen sc1
L_k41:
  s_cbranch_execz L_k42
  buffer_load_dwordx4 v[136:139], v4, s[24:27], 0 offen sc1
L_k42:
L_mp:
  s_waitcnt vmcnt(2)
  v_cmpx_eq_u64 vcc, s[46:47], v[130:131]
  s_and_b32 exec_lo, s48, 0xffffff
  s_cmp_eq_u32 vcc_lo, 0xffffff
  s_cbranch_scc1 L_mpd0
  s_cbranch_execz L_k43
  buffer_load_dwordx4 v[128:131], v4, s[24:27], 0 offen sc1
L_k43:
  s_waitcnt vmcnt(2)
  v_cmpx_eq_u64 vcc, s[46:47], v[134:135]
  s_and_b32 exec_lo, s48, 0xffffff
  s_cmp_eq_u32 vcc_lo, 0xffffff
  s_cbranch_scc1 L_mpd1
  s_cbranch_execz L_k44
  buffer_load_dwordx4 v[132:135], v4, s[24:27], 0 offen sc1
L_k44:
  s_waitcnt vmcnt(2)
  v_cmpx_eq_u64 vcc, s[46:47], v[138:139]
  s_and_b32 exec_lo, s48, 0xffffff
  s_cmp_eq_u32 vcc_lo, 0xffffff
  s_cbranch_scc1 L_mpd2
  s_cbranch_execz L_k45
  buffer_load_dwordx4 v[136:139], v4, s[24:27], 0 offen sc1
L_k45:
  s_sub_u32 s9, s9, 1
  s_cmp_lg_u32 s9, 0
  s_cbranch_scc1 L_mp
  s_waitcnt vmcnt(0)
L_mpd2:
  v_lshlrev_b32 v12, 16, v136
  v_and_b32 v13, 0xffff0000, v136
  v_lshlrev_b32 v14, 16, v137
  v_and_b32 v15, 0xffff0000, v137
  s_branch L_mw
L_mpd1:
  v_lshlrev_b32 v12, 16, v132
  v_and_b32 v13, 0xffff0000, v132
  v_lshlrev_b32 v14, 16, v133
  v_and_b32 v15, 0xffff0000, v133
  s_branch L_mw
L_mpd0:
  v_lshlrev_b32 v12, 16, v128
  v_and_b32 v13, 0xffff0000, v128
  v_lshlrev_b32 v14, 16, v129
  v_and_b32 v15, 0xffff0000, v129
L_mw:
  ds_write_b128 v20, v[12:15] offset:3072
  s_waitcnt lgkmcnt(0)
  s_cmp_lg_u32 s48, 0
  s_cbranch_scc1 L_real
  s_mov_b64 s[48:49], -1
  s_mov_b32 s10, 200000
  s_branch L_pass
L_real:
  s_barrier
  s_waitcnt vmcnt(0)
L_end:
  s_endpgm
.section .rodata,"a"
.p2align 6
.amdhsa_kernel standalone__channel_attn_eca__vision_kernel
  .amdhsa_next_free_vgpr 152
  .amdhsa_next_free_sgpr 72
  .amdhsa_accum_offset 152
  .amdhsa_group_segment_fixed_size 0
  .amdhsa_kernarg_size 40
  .amdhsa_user_sgpr_count 2
  .amdhsa_user_sgpr_kernarg_segment_ptr 1
  .amdhsa_system_sgpr_workgroup_id_x 1
  .amdhsa_float_denorm_mode_32 3
.end_amdhsa_kernel
```
